```python
import torch

def _softmax(x, axis=-1):
    return torch.softmax(x, dim=axis)
def _gelu(x):
    return torch.nn.functional.gelu(x, approximate="tanh")
def _silu(x):
    return torch.nn.functional.silu(x)
def _sigmoid(x):
    return torch.sigmoid(x)
def _layernorm(x, axis=-1, eps=1e-5):
    m = x.mean(dim=axis, keepdim=True)
    v = x.var(dim=axis, keepdim=True, unbiased=False)
    return (x - m) / torch.sqrt(v + eps)
def _scatter_add(tgt, idx, src, axis=0):
    return tgt.clone().index_add_(axis, idx, src)
def _segment_sum(src, seg, n):
    out = torch.zeros((n,) + src.shape[1:], dtype=src.dtype)
    return out.index_add_(0, seg, src)
def _pad(x, pw):
    flat = tuple(v for pair in reversed(pw) for v in pair)
    return torch.nn.functional.pad(x, flat)

kernel_name = 'standalone__low_rank_proj_linformer__prompt'

def setup_inputs():

    _w = (lambda a: (lambda t: t.to(torch.bfloat16) if t.is_floating_point() else t)(torch.as_tensor(a)))
    B, H, Sq, Skv, Dh, R = 1, 32, 2048, 2048, 128, 16
    return {
        "q": _w((lambda *s: torch.randn(*s, dtype=torch.bfloat16) * 0.8)(B, H, Sq, Dh)),
        "k": _w((lambda *s: torch.randn(*s, dtype=torch.bfloat16) * 0.8)(B, H, Skv, Dh)),
        "v": _w((lambda *s: torch.randn(*s, dtype=torch.bfloat16) * 0.05)(B, H, Skv, Dh)),
        "e_proj": _w((lambda *s: torch.randn(*s, dtype=torch.bfloat16) * 0.8)(R, Skv) * (Skv ** -0.5)),
        "f_proj": _w((lambda *s: torch.randn(*s, dtype=torch.bfloat16) * 0.05)(R, Skv) * (Skv ** -0.5)),
    }

def reference(q, k, v, e_proj, f_proj):
    B, H, Sq, Dh = q.shape
    kp = torch.einsum("rn,bhnd->bhrd", e_proj, k)
    vp = torch.einsum("rn,bhnd->bhrd", f_proj, v)
    scores = torch.einsum("bhqd,bhrd->bhqr", q, kp) * (Dh ** -0.5)
    p = _softmax(scores, axis=-1)
    o = torch.einsum("bhqr,bhrd->bhqd", p, vp)
    return o
```

```asm
; @launch grid=(256,1,1) block=(512,1,1) lds=106496
.amdgcn_target "amdgcn-amd-amdhsa--gfx950"
.text
.globl standalone__low_rank_proj_linformer__prompt_kernel
.p2align 8
.type standalone__low_rank_proj_linformer__prompt_kernel,@function
standalone__low_rank_proj_linformer__prompt_kernel:
    s_load_dwordx16 s[36:51], s[0:1], 0
    s_cmp_ge_u32 s2, 256
    s_cbranch_scc1 L_end
    s_mov_b32 s56, s2
    s_and_b32 s28, s2, 7
    s_lshr_b32 s2, s2, 3
    s_lshl_b32 s28, s28, 5
    s_or_b32 s2, s2, s28
    v_lshrrev_b32 v3, 3, v0
    v_and_b32 v4, 7, v0
    s_and_b32 s28, s2, 31
    s_lshr_b32 s29, s2, 5
    v_lshlrev_b32 v1, 11, v3
    s_lshl_b32 s31, s28, 19
    s_bfe_u32 s30, s2, 0x10005
    s_and_b32 s32, s2, 64
    v_lshl_add_u32 v1, v4, 4, v1
    s_lshl_b32 s33, s30, 18
    s_lshl_b32 s32, s32, 1
    s_add_u32 s33, s33, s31
    s_sub_u32 s6, 0x40000, s32
    s_add_u32 s33, s33, s32
    s_mov_b32 s7, 0x00020000
    s_cmp_ge_u32 s2, 128
    s_waitcnt lgkmcnt(0)
    s_cselect_b32 s4, s40, s38
    s_cselect_b32 s5, s41, s39
    s_cselect_b32 s8, s44, s42
    s_cselect_b32 s9, s45, s43
    s_add_u32 s4, s4, s33
    s_addc_u32 s5, s5, 0
    buffer_load_dwordx4 v[108:111], v1, s[4:7], 0 offen offset:0 nt
    buffer_load_dwordx4 v[112:115], v1, s[4:7], 0 offen offset:256 nt
    buffer_load_dwordx4 v[116:119], v1, s[4:7], 0 offen offset:512 nt
    buffer_load_dwordx4 v[120:123], v1, s[4:7], 0 offen offset:768 nt
    buffer_load_dwordx4 v[124:127], v1, s[4:7], 0 offen offset:1024 nt
    buffer_load_dwordx4 v[128:131], v1, s[4:7], 0 offen offset:1280 nt
    buffer_load_dwordx4 v[132:135], v1, s[4:7], 0 offen offset:1536 nt
    buffer_load_dwordx4 v[136:139], v1, s[4:7], 0 offen offset:1792 nt
    v_and_b32 v6, 15, v0
    v_lshrrev_b32 v3, 4, v0
    s_mov_b32 s53, 0x20000
    v_lshlrev_b32 v2, 12, v6
    s_lshl_b32 s52, s30, 11
    v_lshl_add_u32 v2, v3, 5, v2
    s_mov_b32 s10, 0x10000
    s_mov_b32 s11, 0x00020000
    buffer_load_dwordx4 v[20:23], v2, s[8:11], s52 offen offset:0
    buffer_load_dwordx4 v[24:27], v2, s[8:11], s52 offen offset:16
    buffer_load_dwordx4 v[28:31], v2, s[8:11], s52 offen offset:1024
    buffer_load_dwordx4 v[32:35], v2, s[8:11], s52 offen offset:1040
    buffer_load_dwordx4 v[140:143], v1, s[4:7], s53 offen offset:0 nt
    buffer_load_dwordx4 v[144:147], v1, s[4:7], s53 offen offset:256 nt
    buffer_load_dwordx4 v[148:151], v1, s[4:7], s53 offen offset:512 nt
    buffer_load_dwordx4 v[152:155], v1, s[4:7], s53 offen offset:768 nt
    buffer_load_dwordx4 v[156:159], v1, s[4:7], s53 offen offset:1024 nt
    buffer_load_dwordx4 v[160:163], v1, s[4:7], s53 offen offset:1280 nt
    buffer_load_dwordx4 v[164:167], v1, s[4:7], s53 offen offset:1536 nt
    buffer_load_dwordx4 v[168:171], v1, s[4:7], s53 offen offset:1792 nt
    v_lshrrev_b32 v18, 6, v0
    s_lshl_b32 s35, s28, 8
    s_add_u32 s35, s35, 0x200000
    v_readfirstlane_b32 s33, v18
    v_mov_b32 v4, 0
    s_mov_b32 s20, s50
    s_mov_b32 s21, s51
    s_mov_b32 s22, 0x400000
    s_mov_b32 s23, 0x00020000
    buffer_load_dword v7, v4, s[20:23], s35 offen sc1
    s_and_b32 s88, s56, 31
    s_lshr_b32 s89, s56, 5
    s_lshl_b32 s91, s88, 8
    s_add_u32 s91, s91, 0x200000
    buffer_load_dword v174, v4, s[20:23], s91 offen sc1
    s_lshl_b32 s31, s88, 19
    s_mov_b32 s84, s48
    s_mov_b32 s85, s49
    s_mov_b32 s86, 256
    s_mov_b32 s87, 0x00020000
    s_lshl_b32 s92, s88, 2
    s_lshl_b32 s34, s89, 16
    s_add_u32 s34, s34, s31
    s_add_u32 s12, s36, s34
    s_addc_u32 s13, s37, 0
    s_add_u32 s16, s46, s34
    s_addc_u32 s17, s47, 0
    s_mov_b32 s14, 0x10000
    s_mov_b32 s15, 0x00020000
    s_mov_b32 s18, 0x10000
    s_mov_b32 s19, 0x00020000
    v_and_b32 v5, 3, v3
    v_and_b32 v16, 63, v0
    v_lshlrev_b32 v16, 4, v16
    v_lshlrev_b32 v3, 2, v5
    v_xor_b32 v3, v3, v6
    v_lshlrev_b32 v3, 4, v3
    v_lshl_add_u32 v8, v5, 8, v3
    v_xor_b32 v9, 16, v8
    v_xor_b32 v10, 32, v8
    v_xor_b32 v11, 48, v8
    s_lshl_b32 s57, s33, 13
    s_add_u32 s58, s57, 4096
    s_mov_b32 m0, s57
    s_nop 0
    buffer_load_dwordx4 v8, s[12:15], s57 offen offset:0 nt lds
    buffer_load_dwordx4 v9, s[12:15], s57 offen offset:1024 nt lds
    buffer_load_dwordx4 v10, s[12:15], s57 offen offset:2048 nt lds
    v_and_b32 v3, 3, v6
    v_xor_b32 v3, v3, v5
    v_lshlrev_b32 v3, 2, v3
    v_lshrrev_b32 v4, 2, v6
    v_or_b32 v3, v3, v4
    v_lshlrev_b32 v3, 4, v3
    v_lshl_add_u32 v3, v6, 8, v3
    v_add_u32 v12, s57, v3
    v_xor_b32 v13, 16, v12
    v_xor_b32 v14, 32, v12
    v_xor_b32 v15, 48, v12
    v_lshlrev_b32 v17, 10, v5
    v_lshl_add_u32 v17, v6, 4, v17
    s_and_b32 s26, s33, 1
    v_and_b32 v3, 7, v6
    v_lshrrev_b32 v4, 3, v6
    s_bitcmp1_b32 s33, 1
    s_cbranch_scc1 L_fv
    v_and_b32 v18, 3, v3
    v_lshlrev_b32 v18, 10, v18
    v_lshrrev_b32 v3, 2, v3
    v_lshl_add_u32 v18, v3, 8, v18
    v_lshl_add_u32 v18, v5, 6, v18
    v_lshl_add_u32 v18, v4, 3, v18
    s_lshl_b32 s26, s26, 9
    s_add_u32 s26, s26, 98304
    s_branch L_fd
L_fv:
    v_lshlrev_b32 v18, 11, v4
    v_lshl_add_u32 v18, v5, 8, v18
    v_lshl_add_u32 v18, v3, 4, v18
    s_lshl_b32 s26, s26, 7
    s_add_u32 s26, s26, 102400
L_fd:
    v_add_u32 v18, s26, v18
    s_lshl_b32 s26, s33, 12
    s_add_u32 s26, s26, 65536
    v_add_u32 v2, s26, v16
    s_lshl_b32 s26, s33, 9
    v_and_b32 v19, 0x1f0, v16
    v_and_b32 v3, 0x200, v16
    v_lshl_add_u32 v1, v3, 5, v19
    s_add_u32 s27, s26, 65536
    v_add_u32 v1, s27, v1
    s_lshl_b32 s30, s28, 15
    s_lshl_b32 s31, s29, 12
    s_add_u32 s31, s31, s30
    s_add_u32 s31, s31, s26
    s_lshl_b32 s26, s33, 13
    s_lshl_b32 s30, s88, 15
    s_add_u32 s54, s30, s26
    s_add_u32 s55, s54, 4096
    s_mov_b32 s24, 0x05040100
    s_mov_b32 s25, 0x07060302
    s_mov_b32 s3, 0
    s_waitcnt vmcnt(13)
    v_perm_b32 v36, v112, v108, s24
    v_perm_b32 v37, v120, v116, s24
    v_perm_b32 v38, v128, v124, s24
    v_perm_b32 v39, v136, v132, s24
    v_perm_b32 v40, v112, v108, s25
    v_perm_b32 v41, v120, v116, s25
    v_perm_b32 v42, v128, v124, s25
    v_perm_b32 v43, v136, v132, s25
    v_mfma_f32_16x16x32_bf16 v[44:47], v[20:23], v[36:39], 0
    v_mfma_f32_16x16x32_bf16 v[76:79], v[24:27], v[36:39], 0
    v_perm_b32 v36, v113, v109, s24
    v_perm_b32 v37, v121, v117, s24
    v_perm_b32 v38, v129, v125, s24
    v_perm_b32 v39, v137, v133, s24
    v_mfma_f32_16x16x32_bf16 v[48:51], v[20:23], v[40:43], 0
    v_mfma_f32_16x16x32_bf16 v[80:83], v[24:27], v[40:43], 0
    v_perm_b32 v40, v113, v109, s25
    v_perm_b32 v41, v121, v117, s25
    v_perm_b32 v42, v129, v125, s25
    v_perm_b32 v43, v137, v133, s25
    v_mfma_f32_16x16x32_bf16 v[52:55], v[20:23], v[36:39], 0
    v_mfma_f32_16x16x32_bf16 v[84:87], v[24:27], v[36:39], 0
    v_perm_b32 v36, v114, v110, s24
    v_perm_b32 v37, v122, v118, s24
    v_perm_b32 v38, v130, v126, s24
    v_perm_b32 v39, v138, v134, s24
    v_mfma_f32_16x16x32_bf16 v[56:59], v[20:23], v[40:43], 0
    v_mfma_f32_16x16x32_bf16 v[88:91], v[24:27], v[40:43], 0
    v_perm_b32 v40, v114, v110, s25
    v_perm_b32 v41, v122, v118, s25
    v_perm_b32 v42, v130, v126, s25
    v_perm_b32 v43, v138, v134, s25
    v_mfma_f32_16x16x32_bf16 v[60:63], v[20:23], v[36:39], 0
    v_mfma_f32_16x16x32_bf16 v[92:95], v[24:27], v[36:39], 0
    v_perm_b32 v36, v115, v111, s24
    v_perm_b32 v37, v123, v119, s24
    v_perm_b32 v38, v131, v127, s24
    v_perm_b32 v39, v139, v135, s24
    v_mfma_f32_16x16x32_bf16 v[64:67], v[20:23], v[40:43], 0
    v_mfma_f32_16x16x32_bf16 v[96:99], v[24:27], v[40:43], 0
    v_perm_b32 v40, v115, v111, s25
    v_perm_b32 v41, v123, v119, s25
    v_perm_b32 v42, v131, v127, s25
    v_perm_b32 v43, v139, v135, s25
    v_mfma_f32_16x16x32_bf16 v[68:71], v[20:23], v[36:39], 0
    v_mfma_f32_16x16x32_bf16 v[100:103], v[24:27], v[36:39], 0
    v_mfma_f32_16x16x32_bf16 v[72:75], v[20:23], v[40:43], 0
    v_mfma_f32_16x16x32_bf16 v[104:107], v[24:27], v[40:43], 0
    s_waitcnt vmcnt(3)
    v_perm_b32 v36, v144, v140, s24
    v_perm_b32 v37, v152, v148, s24
    v_perm_b32 v38, v160, v156, s24
    v_perm_b32 v39, v168, v164, s24
    v_perm_b32 v40, v144, v140, s25
    v_perm_b32 v41, v152, v148, s25
    v_perm_b32 v42, v160, v156, s25
    v_perm_b32 v43, v168, v164, s25
    v_mfma_f32_16x16x32_bf16 v[44:47], v[28:31], v[36:39], v[44:47]
    v_mfma_f32_16x16x32_bf16 v[76:79], v[32:35], v[36:39], v[76:79]
    v_perm_b32 v36, v145, v141, s24
    v_perm_b32 v37, v153, v149, s24
    v_perm_b32 v38, v161, v157, s24
    v_perm_b32 v39, v169, v165, s24
    v_mfma_f32_16x16x32_bf16 v[48:51], v[28:31], v[40:43], v[48:51]
    v_mfma_f32_16x16x32_bf16 v[80:83], v[32:35], v[40:43], v[80:83]
    v_perm_b32 v40, v145, v141, s25
    v_perm_b32 v41, v153, v149, s25
    v_perm_b32 v42, v161, v157, s25
    v_perm_b32 v43, v169, v165, s25
    v_mfma_f32_16x16x32_bf16 v[52:55], v[28:31], v[36:39], v[52:55]
    v_mfma_f32_16x16x32_bf16 v[84:87], v[32:35], v[36:39], v[84:87]
    v_perm_b32 v36, v146, v142, s24
    v_perm_b32 v37, v154, v150, s24
    v_perm_b32 v38, v162, v158, s24
    v_perm_b32 v39, v170, v166, s24
    v_mfma_f32_16x16x32_bf16 v[56:59], v[28:31], v[40:43], v[56:59]
    v_mfma_f32_16x16x32_bf16 v[88:91], v[32:35], v[40:43], v[88:91]
    v_perm_b32 v40, v146, v142, s25
    v_perm_b32 v41, v154, v150, s25
    v_perm_b32 v42, v162, v158, s25
    v_perm_b32 v43, v170, v166, s25
    v_mfma_f32_16x16x32_bf16 v[60:63], v[28:31], v[36:39], v[60:63]
    v_mfma_f32_16x16x32_bf16 v[92:95], v[32:35], v[36:39], v[92:95]
    v_perm_b32 v36, v147, v143, s24
    v_perm_b32 v37, v155, v151, s24
    v_perm_b32 v38, v163, v159, s24
    v_perm_b32 v39, v171, v167, s24
    v_mfma_f32_16x16x32_bf16 v[64:67], v[28:31], v[40:43], v[64:67]
    v_mfma_f32_16x16x32_bf16 v[96:99], v[32:35], v[40:43], v[96:99]
    v_perm_b32 v40, v147, v143, s25
    v_perm_b32 v41, v155, v151, s25
    v_perm_b32 v42, v163, v159, s25
    v_perm_b32 v43, v171, v167, s25
    v_mfma_f32_16x16x32_bf16 v[68:71], v[28:31], v[36:39], v[68:71]
    v_mfma_f32_16x16x32_bf16 v[100:103], v[32:35], v[36:39], v[100:103]
    v_mfma_f32_16x16x32_bf16 v[72:75], v[28:31], v[40:43], v[72:75]
    v_mfma_f32_16x16x32_bf16 v[104:107], v[32:35], v[40:43], v[104:107]
    v_readfirstlane_b32 s59, v7
    s_add_u32 s59, s59, 1
    s_and_b32 s26, s59, 0x3ff
    s_mov_b32 s27, 0xfffffc00
    v_mov_b32 v7, s26
    v_readfirstlane_b32 s90, v174
    s_add_u32 s90, s90, 1
    s_and_b32 s26, s90, 0x3ff
    v_mov_b32 v174, s26
    v_add_f32_dpp v108, v76, v44 row_ror:8 row_mask:0xf bank_mask:0x3
    v_add_f32_dpp v109, v77, v45 row_ror:8 row_mask:0xf bank_mask:0x3
    v_add_f32_dpp v110, v78, v46 row_ror:8 row_mask:0xf bank_mask:0x3
    v_add_f32_dpp v111, v79, v47 row_ror:8 row_mask:0xf bank_mask:0x3
    v_add_f32_dpp v112, v80, v48 row_ror:8 row_mask:0xf bank_mask:0x3
    v_add_f32_dpp v113, v81, v49 row_ror:8 row_mask:0xf bank_mask:0x3
    v_add_f32_dpp v114, v82, v50 row_ror:8 row_mask:0xf bank_mask:0x3
    v_add_f32_dpp v115, v83, v51 row_ror:8 row_mask:0xf bank_mask:0x3
    v_add_f32_dpp v116, v84, v52 row_ror:8 row_mask:0xf bank_mask:0x3
    v_add_f32_dpp v117, v85, v53 row_ror:8 row_mask:0xf bank_mask:0x3
    v_add_f32_dpp v118, v86, v54 row_ror:8 row_mask:0xf bank_mask:0x3
    v_add_f32_dpp v119, v87, v55 row_ror:8 row_mask:0xf bank_mask:0x3
    v_add_f32_dpp v120, v88, v56 row_ror:8 row_mask:0xf bank_mask:0x3
    v_add_f32_dpp v121, v89, v57 row_ror:8 row_mask:0xf bank_mask:0x3
    v_add_f32_dpp v122, v90, v58 row_ror:8 row_mask:0xf bank_mask:0x3
    v_add_f32_dpp v123, v91, v59 row_ror:8 row_mask:0xf bank_mask:0x3
    v_add_f32_dpp v108, v60, v92 row_ror:8 row_mask:0xf bank_mask:0xc
    v_add_f32_dpp v109, v61, v93 row_ror:8 row_mask:0xf bank_mask:0xc
    v_add_f32_dpp v110, v62, v94 row_ror:8 row_mask:0xf bank_mask:0xc
    v_add_f32_dpp v111, v63, v95 row_ror:8 row_mask:0xf bank_mask:0xc
    ds_write_b128 v2, v[108:111] offset:0
    v_add_f32_dpp v112, v64, v96 row_ror:8 row_mask:0xf bank_mask:0xc
    v_add_f32_dpp v113, v65, v97 row_ror:8 row_mask:0xf bank_mask:0xc
    v_add_f32_dpp v114, v66, v98 row_ror:8 row_mask:0xf bank_mask:0xc
    v_add_f32_dpp v115, v67, v99 row_ror:8 row_mask:0xf bank_mask:0xc
    ds_write_b128 v2, v[112:115] offset:1024
    v_add_f32_dpp v116, v68, v100 row_ror:8 row_mask:0xf bank_mask:0xc
    v_add_f32_dpp v117, v69, v101 row_ror:8 row_mask:0xf bank_mask:0xc
    v_add_f32_dpp v118, v70, v102 row_ror:8 row_mask:0xf bank_mask:0xc
    v_add_f32_dpp v119, v71, v103 row_ror:8 row_mask:0xf bank_mask:0xc
    ds_write_b128 v2, v[116:119] offset:2048
    v_add_f32_dpp v120, v72, v104 row_ror:8 row_mask:0xf bank_mask:0xc
    v_add_f32_dpp v121, v73, v105 row_ror:8 row_mask:0xf bank_mask:0xc
    v_add_f32_dpp v122, v74, v106 row_ror:8 row_mask:0xf bank_mask:0xc
    v_add_f32_dpp v123, v75, v107 row_ror:8 row_mask:0xf bank_mask:0xc
    ds_write_b128 v2, v[120:123] offset:3072
    s_waitcnt lgkmcnt(0)
    s_barrier
    ds_read_b128 v[44:47], v1 offset:0
    ds_read_b128 v[48:51], v1 offset:4096
    ds_read_b128 v[52:55], v1 offset:8192
    ds_read_b128 v[56:59], v1 offset:12288
    s_waitcnt lgkmcnt(2)
    v_pk_add_f32 v[44:45], v[44:45], v[48:49]
    v_pk_add_f32 v[46:47], v[46:47], v[50:51]
    s_waitcnt lgkmcnt(0)
    v_pk_add_f32 v[52:53], v[52:53], v[56:57]
    v_pk_add_f32 v[54:55], v[54:55], v[58:59]
    v_pk_add_f32 v[48:49], v[44:45], v[52:53]
    v_pk_add_f32 v[50:51], v[46:47], v[54:55]
    v_pk_add_f32 v[44:45], v[44:45], v[52:53]
    v_pk_add_f32 v[46:47], v[46:47], v[54:55]
    s_nop 1
    v_permlane32_swap_b32 v44, v48
    v_permlane32_swap_b32 v45, v49
    v_permlane32_swap_b32 v46, v50
    v_permlane32_swap_b32 v47, v51
    s_mov_b32 exec_hi, 0
    v_pk_add_f32 v[44:45], v[44:45], v[48:49]
    v_pk_add_f32 v[46:47], v[46:47], v[50:51]
    v_and_or_b32 v44, v44, s27, v7
    v_and_or_b32 v45, v45, s27, v7
    v_and_or_b32 v46, v46, s27, v7
    v_and_or_b32 v47, v47, s27, v7
    buffer_store_dwordx4 v[44:47], v19, s[20:23], s31 offen sc1
    s_mov_b32 exec_hi, -1
    s_cmp_ge_u32 s33, 4
    s_cbranch_scc1 L_nog
    s_mov_b32 m0, s57
    s_nop 0
    buffer_load_dwordx4 v11, s[12:15], s57 offen offset:3072 nt lds
    s_mov_b32 m0, s58
    s_nop 0
    buffer_load_dwordx4 v8, s[12:15], s58 offen offset:0 nt lds
    buffer_load_dwordx4 v9, s[12:15], s58 offen offset:1024 nt lds
    buffer_load_dwordx4 v10, s[12:15], s58 offen offset:2048 nt lds
    buffer_load_dwordx4 v11, s[12:15], s58 offen offset:3072 nt lds
    s_waitcnt vmcnt(0)
    buffer_load_dwordx4 v[60:63], v16, s[20:23], s54 offen offset:0 sc1
    buffer_load_dwordx4 v[64:67], v16, s[20:23], s54 offen offset:1024 sc1
    buffer_load_dwordx4 v[68:71], v16, s[20:23], s54 offen offset:2048 sc1
    buffer_load_dwordx4 v[72:75], v16, s[20:23], s54 offen offset:3072 sc1
    buffer_load_dwordx4 v[76:79], v16, s[20:23], s55 offen offset:0 sc1
    buffer_load_dwordx4 v[80:83], v16, s[20:23], s55 offen offset:1024 sc1
    buffer_load_dwordx4 v[84:87], v16, s[20:23], s55 offen offset:2048 sc1
    buffer_load_dwordx4 v[88:91], v16, s[20:23], s55 offen offset:3072 sc1
    ds_read_b128 v[140:143], v12 offset:0
    ds_read_b128 v[144:147], v13 offset:0
    ds_read_b128 v[148:151], v14 offset:0
    ds_read_b128 v[152:155], v15 offset:0
    ds_read_b128 v[156:159], v12 offset:4096
    ds_read_b128 v[160:163], v13 offset:4096
    ds_read_b128 v[164:167], v14 offset:4096
    ds_read_b128 v[168:171], v15 offset:4096
    s_waitcnt vmcnt(0)
L_chk:
    v_xor_b32 v60, v174, v60
    v_xor_b32 v61, v174, v61
    v_xor_b32 v62, v174, v62
    v_xor_b32 v63, v174, v63
    v_xor_b32 v64, v174, v64
    v_xor_b32 v65, v174, v65
    v_xor_b32 v66, v174, v66
    v_xor_b32 v67, v174, v67
    v_xor_b32 v68, v174, v68
    v_xor_b32 v69, v174, v69
    v_xor_b32 v70, v174, v70
    v_xor_b32 v71, v174, v71
    v_xor_b32 v72, v174, v72
    v_xor_b32 v73, v174, v73
    v_xor_b32 v74, v174, v74
    v_xor_b32 v75, v174, v75
    v_xor_b32 v76, v174, v76
    v_xor_b32 v77, v174, v77
    v_xor_b32 v78, v174, v78
    v_xor_b32 v79, v174, v79
    v_xor_b32 v80, v174, v80
    v_xor_b32 v81, v174, v81
    v_xor_b32 v82, v174, v82
    v_xor_b32 v83, v174, v83
    v_xor_b32 v84, v174, v84
    v_xor_b32 v85, v174, v85
    v_xor_b32 v86, v174, v86
    v_xor_b32 v87, v174, v87
    v_xor_b32 v88, v174, v88
    v_xor_b32 v89, v174, v89
    v_xor_b32 v90, v174, v90
    v_xor_b32 v91, v174, v91
    v_or3_b32 v3, v60, v61, v62
    v_or3_b32 v4, v63, v64, v65
    v_or3_b32 v3, v3, v66, v67
    v_or3_b32 v4, v4, v68, v69
    v_or3_b32 v3, v3, v70, v71
    v_or3_b32 v4, v4, v72, v73
    v_or3_b32 v3, v3, v74, v75
    v_or3_b32 v4, v4, v76, v77
    v_or3_b32 v3, v3, v78, v79
    v_or3_b32 v4, v4, v80, v81
    v_or3_b32 v3, v3, v82, v83
    v_or3_b32 v4, v4, v84, v85
    v_or3_b32 v3, v3, v86, v87
    v_or3_b32 v4, v4, v88, v89
    v_or3_b32 v3, v3, v90, v91
    v_pk_add_f32 v[60:61], v[60:61], v[76:77]
    v_pk_add_f32 v[62:63], v[62:63], v[78:79]
    v_pk_add_f32 v[64:65], v[64:65], v[80:81]
    v_pk_add_f32 v[66:67], v[66:67], v[82:83]
    v_pk_add_f32 v[68:69], v[68:69], v[84:85]
    v_pk_add_f32 v[70:71], v[70:71], v[86:87]
    v_pk_add_f32 v[72:73], v[72:73], v[88:89]
    v_pk_add_f32 v[74:75], v[74:75], v[90:91]
    v_or_b32 v3, v3, v4
    v_and_b32 v3, 0x3ff, v3
    v_cmp_ne_u32 vcc, 0, v3
    s_cbranch_vccnz L_retry
L_got:
    s_bitcmp1_b32 s33, 1
    s_cbranch_scc1 L_wv
    v_cvt_pk_bf16_f32 v36, v60, v64
    v_cvt_pk_bf16_f32 v37, v68, v72
    v_cvt_pk_bf16_f32 v38, v61, v65
    v_cvt_pk_bf16_f32 v39, v69, v73
    v_cvt_pk_bf16_f32 v40, v62, v66
    v_cvt_pk_bf16_f32 v41, v70, v74
    v_cvt_pk_bf16_f32 v42, v63, v67
    v_cvt_pk_bf16_f32 v43, v71, v75
    ds_write_b64 v18, v[36:37] offset:0
    ds_write_b64 v18, v[38:39] offset:16
    ds_write_b64 v18, v[40:41] offset:32
    ds_write_b64 v18, v[42:43] offset:48
    s_branch L_wd
L_retry:
    s_add_u32 s3, s3, 1
    s_cmp_ge_u32 s3, 0x8000
    s_cbranch_scc1 L_got
    buffer_load_dwordx4 v[60:63], v16, s[20:23], s54 offen offset:0 sc1
    buffer_load_dwordx4 v[64:67], v16, s[20:23], s54 offen offset:1024 sc1
    buffer_load_dwordx4 v[68:71], v16, s[20:23], s54 offen offset:2048 sc1
    buffer_load_dwordx4 v[72:75], v16, s[20:23], s54 offen offset:3072 sc1
    buffer_load_dwordx4 v[76:79], v16, s[20:23], s55 offen offset:0 sc1
    buffer_load_dwordx4 v[80:83], v16, s[20:23], s55 offen offset:1024 sc1
    buffer_load_dwordx4 v[84:87], v16, s[20:23], s55 offen offset:2048 sc1
    buffer_load_dwordx4 v[88:91], v16, s[20:23], s55 offen offset:3072 sc1
    s_waitcnt vmcnt(0)
    s_cmp_lt_u32 s3, 64
    s_cbranch_scc1 L_chk
    v_mov_b32 v4, 0
    buffer_load_dword v3, v4, s[84:87], s92 offen sc1
    s_waitcnt vmcnt(0)
    v_cmp_ne_u32 vcc, 0, v3
    v_and_b32 v3, 0x3ff, v3
    s_nop 1
    v_cndmask_b32 v174, v174, v3, vcc
    s_branch L_chk
L_nog:
    s_mov_b32 m0, s57
    s_nop 0
    buffer_load_dwordx4 v11, s[12:15], s57 offen offset:3072 nt lds
    s_mov_b32 m0, s58
    s_nop 0
    buffer_load_dwordx4 v8, s[12:15], s58 offen offset:0 nt lds
    buffer_load_dwordx4 v9, s[12:15], s58 offen offset:1024 nt lds
    buffer_load_dwordx4 v10, s[12:15], s58 offen offset:2048 nt lds
    buffer_load_dwordx4 v11, s[12:15], s58 offen offset:3072 nt lds
    s_waitcnt vmcnt(4)
    ds_read_b128 v[140:143], v12 offset:0
    ds_read_b128 v[144:147], v13 offset:0
    ds_read_b128 v[148:151], v14 offset:0
    ds_read_b128 v[152:155], v15 offset:0
    s_waitcnt vmcnt(0)
    ds_read_b128 v[156:159], v12 offset:4096
    ds_read_b128 v[160:163], v13 offset:4096
    ds_read_b128 v[164:167], v14 offset:4096
    ds_read_b128 v[168:171], v15 offset:4096
    s_branch L_wd
L_wv:
    v_cvt_pk_bf16_f32 v36, v60, v61
    v_cvt_pk_bf16_f32 v37, v62, v63
    v_cvt_pk_bf16_f32 v38, v64, v65
    v_cvt_pk_bf16_f32 v39, v66, v67
    v_cvt_pk_bf16_f32 v40, v68, v69
    v_cvt_pk_bf16_f32 v41, v70, v71
    v_cvt_pk_bf16_f32 v42, v72, v73
    v_cvt_pk_bf16_f32 v43, v74, v75
    ds_write_b128 v18, v[36:39] offset:0
    ds_write_b128 v18, v[40:43] offset:1024
L_wd:
    v_add_u32 v3, 98304, v16
    s_mov_b32 s26, 0x3e0293ee
    s_waitcnt lgkmcnt(0)
    s_barrier
    ds_read_b128 v[44:47], v3 offset:0
    ds_read_b128 v[48:51], v3 offset:1024
    ds_read_b128 v[52:55], v3 offset:2048
    ds_read_b128 v[56:59], v3 offset:3072
    ds_read_b128 v[60:63], v3 offset:4096
    ds_read_b128 v[64:67], v3 offset:5120
    ds_read_b128 v[68:71], v3 offset:6144
    ds_read_b128 v[72:75], v3 offset:7168
    s_or_b32 s27, s89, s33
    s_cbranch_scc1 L_nodbg
    v_or_b32 v174, 0x400, v174
    v_mov_b32 v4, 0
    buffer_store_dword v174, v4, s[84:87], s92 offen sc1
L_nodbg:
    s_waitcnt lgkmcnt(7)
    v_mfma_f32_16x16x32_bf16 v[20:23], v[44:47], v[140:143], 0
    v_mfma_f32_16x16x32_bf16 v[24:27], v[44:47], v[156:159], 0
    s_waitcnt lgkmcnt(6)
    v_mfma_f32_16x16x32_bf16 v[20:23], v[48:51], v[144:147], v[20:23]
    v_mfma_f32_16x16x32_bf16 v[24:27], v[48:51], v[160:163], v[24:27]
    s_waitcnt lgkmcnt(5)
    v_mfma_f32_16x16x32_bf16 v[20:23], v[52:55], v[148:151], v[20:23]
    v_mfma_f32_16x16x32_bf16 v[24:27], v[52:55], v[164:167], v[24:27]
    s_waitcnt lgkmcnt(4)
    v_mfma_f32_16x16x32_bf16 v[20:23], v[56:59], v[152:155], v[20:23]
    v_mfma_f32_16x16x32_bf16 v[24:27], v[56:59], v[168:171], v[24:27]
    s_nop 7
    v_max3_f32 v36, v20, v21, v22
    v_max3_f32 v40, v24, v25, v26
    v_max_f32 v36, v36, v23
    v_max_f32 v40, v40, v27
    v_mov_b32 v37, v36
    v_mov_b32 v41, v40
    s_nop 0
    v_permlane32_swap_b32 v36, v37
    v_permlane32_swap_b32 v40, v41
    v_max_f32 v36, v36, v37
    v_max_f32 v40, v40, v41
    v_mov_b32 v37, v36
    v_mov_b32 v41, v40
    s_nop 0
    v_permlane16_swap_b32 v36, v37
    v_permlane16_swap_b32 v40, v41
    v_max_f32 v36, v36, v37
    v_max_f32 v40, v40, v41
    v_mul_f32 v36, s26, v36
    v_mul_f32 v40, s26, v40
    v_fma_f32 v20, v20, s26, -v36
    v_fma_f32 v21, v21, s26, -v36
    v_fma_f32 v22, v22, s26, -v36
    v_fma_f32 v23, v23, s26, -v36
    v_fma_f32 v24, v24, s26, -v40
    v_fma_f32 v25, v25, s26, -v40
    v_fma_f32 v26, v26, s26, -v40
    v_fma_f32 v27, v27, s26, -v40
    v_exp_f32 v20, v20
    v_exp_f32 v21, v21
    v_exp_f32 v22, v22
    v_exp_f32 v23, v23
    v_exp_f32 v24, v24
    v_exp_f32 v25, v25
    v_exp_f32 v26, v26
    v_exp_f32 v27, v27
    v_add_f32 v36, v20, v21
    v_add_f32 v37, v22, v23
    v_add_f32 v40, v24, v25
    v_add_f32 v41, v26, v27
    v_add_f32 v36, v36, v37
    v_add_f32 v40, v40, v41
    v_mov_b32 v37, v36
    v_mov_b32 v41, v40
    s_nop 0
    v_permlane32_swap_b32 v36, v37
    v_permlane32_swap_b32 v40, v41
    v_add_f32 v36, v36, v37
    v_add_f32 v40, v40, v41
    v_mov_b32 v37, v36
    v_mov_b32 v41, v40
    s_nop 0
    v_permlane16_swap_b32 v36, v37
    v_permlane16_swap_b32 v40, v41
    v_add_f32 v36, v36, v37
    v_add_f32 v40, v40, v41
    v_rcp_f32 v36, v36
    v_rcp_f32 v40, v40
    v_mul_f32 v20, v20, v36
    v_mul_f32 v21, v21, v36
    v_mul_f32 v22, v22, v36
    v_mul_f32 v23, v23, v36
    v_mul_f32 v24, v24, v40
    v_mul_f32 v25, v25, v40
    v_mul_f32 v26, v26, v40
    v_mul_f32 v27, v27, v40
    v_cvt_pk_bf16_f32 v38, v20, v21
    v_cvt_pk_bf16_f32 v39, v22, v23
    v_cvt_pk_bf16_f32 v42, v24, v25
    v_cvt_pk_bf16_f32 v43, v26, v27
    s_waitcnt lgkmcnt(0)
    v_mfma_f32_16x16x16_bf16 v[76:79], v[38:39], v[60:61], 0
    v_mfma_f32_16x16x16_bf16 v[80:83], v[38:39], v[62:63], 0
    v_mfma_f32_16x16x16_bf16 v[84:87], v[38:39], v[64:65], 0
    v_mfma_f32_16x16x16_bf16 v[88:91], v[38:39], v[66:67], 0
    v_mfma_f32_16x16x16_bf16 v[92:95], v[38:39], v[68:69], 0
    v_mfma_f32_16x16x16_bf16 v[96:99], v[38:39], v[70:71], 0
    v_mfma_f32_16x16x16_bf16 v[100:103], v[38:39], v[72:73], 0
    v_mfma_f32_16x16x16_bf16 v[104:107], v[38:39], v[74:75], 0
    v_mfma_f32_16x16x16_bf16 v[140:143], v[42:43], v[60:61], 0
    v_mfma_f32_16x16x16_bf16 v[144:147], v[42:43], v[62:63], 0
    v_mfma_f32_16x16x16_bf16 v[148:151], v[42:43], v[64:65], 0
    v_mfma_f32_16x16x16_bf16 v[152:155], v[42:43], v[66:67], 0
    v_mfma_f32_16x16x16_bf16 v[156:159], v[42:43], v[68:69], 0
    v_mfma_f32_16x16x16_bf16 v[160:163], v[42:43], v[70:71], 0
    v_mfma_f32_16x16x16_bf16 v[164:167], v[42:43], v[72:73], 0
    v_mfma_f32_16x16x16_bf16 v[168:171], v[42:43], v[74:75], 0
    v_cvt_pk_bf16_f32 v108, v76, v80
    v_cvt_pk_bf16_f32 v109, v84, v88
    v_cvt_pk_bf16_f32 v110, v92, v96
    v_cvt_pk_bf16_f32 v111, v100, v104
    buffer_store_dwordx4 v[108:111], v17, s[16:19], s57 offen offset:0 sc0 sc1 nt
    v_cvt_pk_bf16_f32 v112, v77, v81
    v_cvt_pk_bf16_f32 v113, v85, v89
    v_cvt_pk_bf16_f32 v114, v93, v97
    v_cvt_pk_bf16_f32 v115, v101, v105
    buffer_store_dwordx4 v[112:115], v17, s[16:19], s57 offen offset:256 sc0 sc1 nt
    v_cvt_pk_bf16_f32 v116, v78, v82
    v_cvt_pk_bf16_f32 v117, v86, v90
    v_cvt_pk_bf16_f32 v118, v94, v98
    v_cvt_pk_bf16_f32 v119, v102, v106
    buffer_store_dwordx4 v[116:119], v17, s[16:19], s57 offen offset:512 sc0 sc1 nt
    v_cvt_pk_bf16_f32 v120, v79, v83
    v_cvt_pk_bf16_f32 v121, v87, v91
    v_cvt_pk_bf16_f32 v122, v95, v99
    v_cvt_pk_bf16_f32 v123, v103, v107
    buffer_store_dwordx4 v[120:123], v17, s[16:19], s57 offen offset:768 sc0 sc1 nt
    v_cvt_pk_bf16_f32 v124, v140, v144
    v_cvt_pk_bf16_f32 v125, v148, v152
    v_cvt_pk_bf16_f32 v126, v156, v160
    v_cvt_pk_bf16_f32 v127, v164, v168
    buffer_store_dwordx4 v[124:127], v17, s[16:19], s58 offen offset:0 sc0 sc1 nt
    v_cvt_pk_bf16_f32 v128, v141, v145
    v_cvt_pk_bf16_f32 v129, v149, v153
    v_cvt_pk_bf16_f32 v130, v157, v161
    v_cvt_pk_bf16_f32 v131, v165, v169
    buffer_store_dwordx4 v[128:131], v17, s[16:19], s58 offen offset:256 sc0 sc1 nt
    v_cvt_pk_bf16_f32 v132, v142, v146
    v_cvt_pk_bf16_f32 v133, v150, v154
    v_cvt_pk_bf16_f32 v134, v158, v162
    v_cvt_pk_bf16_f32 v135, v166, v170
    buffer_store_dwordx4 v[132:135], v17, s[16:19], s58 offen offset:512 sc0 sc1 nt
    v_cvt_pk_bf16_f32 v136, v143, v147
    v_cvt_pk_bf16_f32 v137, v151, v155
    v_cvt_pk_bf16_f32 v138, v159, v163
    v_cvt_pk_bf16_f32 v139, v167, v171
    buffer_store_dwordx4 v[136:139], v17, s[16:19], s58 offen offset:768 sc0 sc1 nt
    s_or_b32 s26, s89, s33
    s_cmp_lg_u32 s26, 0
    s_cbranch_scc1 L_nobump
    v_mov_b32 v3, s90
    s_waitcnt vmcnt(8)
    v_mov_b32 v4, 0
    buffer_store_dword v3, v4, s[20:23], s91 offen sc1
L_nobump:
L_end:
    s_endpgm
.section .rodata,"a"
.p2align 6
.amdhsa_kernel standalone__low_rank_proj_linformer__prompt_kernel
  .amdhsa_next_free_vgpr 176
  .amdhsa_next_free_sgpr 96
  .amdhsa_accum_offset 176
  .amdhsa_group_segment_fixed_size 0
  .amdhsa_kernarg_size 64
  .amdhsa_user_sgpr_count 2
  .amdhsa_user_sgpr_kernarg_segment_ptr 1
  .amdhsa_system_sgpr_workgroup_id_x 1
.end_amdhsa_kernel
```
